```python
import torch

def _softmax(x, axis=-1):
    return torch.softmax(x, dim=axis)
def _gelu(x):
    return torch.nn.functional.gelu(x, approximate="tanh")
def _silu(x):
    return torch.nn.functional.silu(x)
def _sigmoid(x):
    return torch.sigmoid(x)
def _layernorm(x, axis=-1, eps=1e-5):
    m = x.mean(dim=axis, keepdim=True)
    v = x.var(dim=axis, keepdim=True, unbiased=False)
    return (x - m) / torch.sqrt(v + eps)
def _scatter_add(tgt, idx, src, axis=0):
    return tgt.clone().index_add_(axis, idx, src)
def _segment_sum(src, seg, n):
    out = torch.zeros((n,) + src.shape[1:], dtype=src.dtype)
    return out.index_add_(0, seg, src)
def _pad(x, pw):
    flat = tuple(v for pair in reversed(pw) for v in pair)
    return torch.nn.functional.pad(x, flat)

kernel_name = 'standalone__linear_kernel_rfa__decode'

def setup_inputs():

    _w = (lambda a: (lambda t: t.to(torch.bfloat16) if t.is_floating_point() else t)(torch.as_tensor(a)))
    B, H, Sq, Sk, D, M = 4, 32, 1, 4096, 128, 8
    return {
        "q": _w((lambda *s: torch.randn(*s, dtype=torch.bfloat16) * 0.05)(B, H, Sq, D)),
        "k": _w((lambda *s: torch.randn(*s, dtype=torch.bfloat16) * 0.4)(B, H, Sk, D)),
        "v": _w((lambda *s: torch.randn(*s, dtype=torch.bfloat16) * 0.4)(B, H, Sk, D)),
        "omega": _w((lambda *s: torch.randn(*s, dtype=torch.bfloat16) * 0.8)(M, D)),
    }

def reference(q, k, v, omega):
    d = q.shape[-1]
    m = omega.shape[0]
    scale = float(d) ** -0.25
    qs = q * scale
    ks = k * scale
    q_proj = torch.einsum("bhsd,md->bhsm", qs, omega)
    k_proj = torch.einsum("bhsd,md->bhsm", ks, omega)
    q_sq = 0.5 * torch.einsum("bhsd,bhsd->bhs", qs, qs)[..., None]
    k_sq = 0.5 * torch.einsum("bhsd,bhsd->bhs", ks, ks)[..., None]
    inv_sqrt_m = float(m) ** -0.5
    phi_q = torch.exp(q_proj - q_sq) * inv_sqrt_m + 1e-6
    phi_k = torch.exp(k_proj - k_sq) * inv_sqrt_m + 1e-6
    kv = torch.einsum("bhsm,bhsd->bhmd", phi_k, v)
    z  = torch.einsum("bhsm->bhm", phi_k)
    num = torch.einsum("bhqm,bhmd->bhqd", phi_q, kv)
    den = torch.einsum("bhqm,bhm->bhq", phi_q, z)[..., None] + 1e-6
    return num / den
```

```asm
; @launch grid=(256,1,1) block=(320,1,1) lds=77888
.amdgcn_target "amdgcn-amd-amdhsa--gfx950"
.text
.globl standalone__linear_kernel_rfa__decode_kernel
.p2align 12
.p2align 8
.type standalone__linear_kernel_rfa__decode_kernel,@function
standalone__linear_kernel_rfa__decode_kernel:
    s_load_dwordx8 s[4:11], s[0:1], 0
    s_load_dwordx4 s[12:15], s[0:1], 32
    s_load_dwordx2 s[16:17], s[0:1], 48
    v_readfirstlane_b32 s70, v0
    s_cmpk_ge_u32 s2, 256
    s_cbranch_scc1 L_end
    v_and_b32 v39, 63, v0
    s_and_b32 s50, s2, 7
    s_lshr_b32 s18, s2, 4
    s_lshl3_add_u32 s50, s18, s50
    v_lshlrev_b32 v39, 4, v39
    s_mov_b32 s23, 0x20000
    s_sub_u32 s70, s70, 64
    s_cbranch_scc0 L_stream
    s_and_b32 s19, s2, 0xe8
    s_cbranch_scc1 L_helper
    s_lshl_b32 s18, s50, 10
    s_mov_b32 s22, 0x24000
    v_mov_b32 v24, -1
    v_mov_b32 v25, -1
    v_mov_b32 v26, -1
    v_mov_b32 v27, -1
    s_waitcnt lgkmcnt(0)
    s_mov_b64 s[20:21], s[16:17]
L_init:
    buffer_store_dwordx4 v[24:27], v39, s[20:23], s18 offen sc0 sc1
    s_addk_i32 s18, 0x4000
    s_cmp_lt_u32 s18, s22
    s_cbranch_scc1 L_init
    s_branch L_helper
L_stream:
    s_setprio 3
    s_and_b32 s3, s2, 8
    s_lshl_b32 s3, s3, 12
    s_lshl_b32 s18, s70, 6
    s_or_b32 s3, s3, s18
    v_add_u32 v5, s3, v39
    v_and_b32 v23, 48, v0
    v_lshlrev_b32 v23, 2, v23
    v_xor_b32 v1, v5, v23
    v_xor_b32 v2, 16, v1
    v_xor_b32 v3, 32, v1
    v_xor_b32 v4, 48, v1
    s_lshl_b32 s71, s70, 8
    s_lshl_b32 s19, s70, 4
    s_add_u32 m0, s19, 73728
    s_mov_b32 s31, s23
    s_movk_i32 s30, 256
    s_lshl_b32 s18, s50, 20
    s_lshl_b32 s55, s50, 8
    s_mov_b32 s22, 0x100000
    s_movk_i32 s48, 0x4000
    s_movk_i32 s73, 0x1000
    s_cmpk_lt_u32 s70, 128
    s_cselect_b32 s19, s19, s55
    s_cselect_b32 s30, 1024, s30
    s_waitcnt lgkmcnt(0)
    s_cselect_b64 s[28:29], s[10:11], s[4:5]
    s_add_u32 s28, s28, s19
    s_addc_u32 s29, s29, 0
    buffer_load_dwordx4 v39, s[28:31], 0 offen lds
    s_mov_b32 m0, s71
    s_add_u32 s20, s6, s18
    s_addc_u32 s21, s7, 0
    buffer_load_dwordx4 v1, s[20:23], 0 offen offset:0 nt lds
    buffer_load_dwordx4 v2, s[20:23], 0 offen offset:1024 nt lds
    buffer_load_dwordx4 v3, s[20:23], 0 offen offset:2048 nt lds
    buffer_load_dwordx4 v4, s[20:23], 0 offen offset:3072 nt lds
    s_or_b32 m0, s71, s73
    s_add_u32 s24, s8, s18
    buffer_load_dwordx4 v1, s[20:23], s48 offen offset:0 nt lds
    buffer_load_dwordx4 v2, s[20:23], s48 offen offset:1024 nt lds
    buffer_load_dwordx4 v3, s[20:23], s48 offen offset:2048 nt lds
    buffer_load_dwordx4 v4, s[20:23], s48 offen offset:3072 nt lds
    s_addc_u32 s25, s9, 0
    v_subrev_u32 v0, 64, v0
    v_and_b32 v21, 15, v0
    v_bfe_u32 v22, v0, 4, 2
    v_and_b32 v16, 3, v21
    v_lshlrev_b32 v16, 10, v16
    v_lshrrev_b32 v17, 2, v21
    v_lshl_add_u32 v16, v17, 8, v16
    v_xor_b32 v18, v22, v21
    v_lshl_add_u32 v28, v18, 4, v16
    v_lshlrev_b32 v17, 1, v17
    v_and_b32 v18, 1, v21
    v_add_u32 v17, v17, v18
    s_mov_b32 s58, 73728
    v_lshl_add_u32 v7, v22, 4, s58
    v_lshl_add_u32 v6, v17, 8, v7
    s_lshl_b32 s59, s70, 5
    s_add_u32 s59, s59, 65536
    v_lshl_add_u32 v29, v21, 2, s59
    v_cmp_gt_u32 vcc, 8, v21
    v_mov_b32 v16, 0x0100
    v_mov_b32 v17, 0x0302
    v_cndmask_b32 v16, v16, v17, vcc
    v_cmp_eq_u32 vcc, 0, v18
    v_or_b32 v17, 0x0c0c0000, v16
    v_lshlrev_b32 v16, 16, v16
    v_or_b32 v16, 0x0c0c, v16
    v_cndmask_b32 v16, v16, v17, vcc
    v_bfe_u32 v18, v21, 1, 2
    v_mov_b32 v17, 0x0c0c0c0c
    v_cmp_eq_u32 vcc, 0, v18
    v_mov_b32 v76, 0
    v_mov_b32 v15, 1.0
    v_cndmask_b32 v10, v17, v16, vcc
    v_cmp_eq_u32 vcc, 1, v18
    v_mov_b32 v77, 0
    v_mov_b32 v33, 0
    v_cndmask_b32 v11, v17, v16, vcc
    v_cmp_eq_u32 vcc, 2, v18
    v_mov_b32 v78, 0
    v_mov_b32 v38, 6
    v_cndmask_b32 v12, v17, v16, vcc
    v_cmp_eq_u32 vcc, 3, v18
    v_mov_b32 v79, 0
    v_mov_b32 v73, 1
    v_cndmask_b32 v13, v17, v16, vcc
    v_mov_b32 v14, 0xbe1837f0
    v_mov_b32 v16, 0
    v_mov_b32 v17, 0
    v_mov_b32 v18, 0
    v_mov_b32 v19, 0
    s_mov_b32 s52, 0x3edb9ada
    s_mov_b32 s53, 0x3eb504f3
    s_mov_b32 s54, 0x358637bd
    s_mov_b32 s74, 0x07060302
    s_lshr_b32 s75, s70, 4
    v_mov_b32 v72, 77856
    v_add_u32 v74, s75, v72
    s_waitcnt vmcnt(8)
    s_barrier
    ds_read_b128 v[40:43], v6 offset:0
    ds_read_b128 v[44:47], v6 offset:64
    ds_read_b128 v[48:51], v6 offset:128
    ds_read_b128 v[52:55], v6 offset:192
    ds_read_b128 v[56:59], v7 offset:2048
    ds_read_b128 v[60:63], v7 offset:2112
    ds_read_b128 v[64:67], v7 offset:2176
    ds_read_b128 v[68:71], v7 offset:2240
    v_mov_b32 v34, 0
    v_mov_b32 v35, 0
    s_waitcnt lgkmcnt(3)
    v_mfma_f32_16x16x32_bf16 v[20:23], v[40:43], v[56:59], 0
    v_dot2c_f32_bf16 v34, v56, v56
    v_dot2c_f32_bf16 v35, v57, v57
    v_dot2c_f32_bf16 v34, v58, v58
    v_dot2c_f32_bf16 v35, v59, v59
    s_waitcnt lgkmcnt(2)
    v_mfma_f32_16x16x32_bf16 v[20:23], v[44:47], v[60:63], v[20:23]
    v_dot2c_f32_bf16 v34, v60, v60
    v_dot2c_f32_bf16 v35, v61, v61
    v_dot2c_f32_bf16 v34, v62, v62
    v_dot2c_f32_bf16 v35, v63, v63
    s_waitcnt lgkmcnt(1)
    v_mfma_f32_16x16x32_bf16 v[20:23], v[48:51], v[64:67], v[20:23]
    v_dot2c_f32_bf16 v34, v64, v64
    v_dot2c_f32_bf16 v35, v65, v65
    v_dot2c_f32_bf16 v34, v66, v66
    v_dot2c_f32_bf16 v35, v67, v67
    s_waitcnt lgkmcnt(0)
    v_mfma_f32_16x16x32_bf16 v[20:23], v[52:55], v[68:71], v[20:23]
    v_dot2c_f32_bf16 v34, v68, v68
    v_dot2c_f32_bf16 v35, v69, v69
    v_dot2c_f32_bf16 v34, v70, v70
    v_dot2c_f32_bf16 v35, v71, v71
    s_nop 2
    v_add_f32 v34, v34, v35
    s_nop 1
    v_mfma_f32_16x16x4_f32 v[20:23], v14, v34, v[20:23]
    s_add_u32 s36, s12, s55
    s_addc_u32 s37, s13, 0
    s_movk_i32 s38, 256
    s_mov_b32 s39, s23
    s_lshl_b32 s56, s50, 10
    s_add_u32 s44, s16, s56
    s_addc_u32 s45, s17, 0
    s_movk_i32 s46, 1024
    s_mov_b32 s47, s23
    v_mov_b32 v36, s54
    v_mul_f32 v30, s52, v20
    v_mul_f32 v31, s52, v21
    v_exp_f32 v30, v30
    v_exp_f32 v31, v31
    s_nop 0
    v_fma_f32 v30, v30, s53, v36
    v_fma_f32 v31, v31, s53, v36
    v_add_f32 v32, v30, v31
    v_mul_f32 v32, s54, v32
    v_mul_f32 v30, s53, v30
    v_mul_f32 v31, s53, v31
L_kloop:
    v_add3_u32 v76, v76, v77, v78
    v_mad_i32_i24 v79, v73, -4, v79
    v_add3_u32 v76, v76, v79, 2
    v_mad_i32_i24 v38, v76, 2, v38
    v_max_i32 v38, 0, v38
    v_add_u32 v73, 1, v73
    v_readfirstlane_b32 s80, v38
    ds_write_b32 v74, v73 offset:16
    ds_read_b32 v38, v72
    ds_read_b128 v[76:79], v72 offset:16
    s_or_b32 s48, s48, 0xffe0bfff
    s_add_u32 s48, s48, 1
    s_and_b32 s48, s48, 0x1f4000
    s_addk_i32 s73, 0x1000
    s_and_b32 s73, s73, 0x3000
    s_or_b32 m0, s71, s73
    s_xor_b32 s72, m0, 0x2000
    s_lshr_b32 s81, s73, 12
    s_add_u32 s80, s80, s81
    s_cmp_lg_u32 s48, s22
    s_cbranch_scc1 L_kgo
    s_mov_b32 s48, 0
    s_mov_b64 s[20:21], s[24:25]
    v_mov_b32 v1, v5
    v_mov_b32 v2, v5
    v_mov_b32 v3, v5
    v_mov_b32 v4, v5
L_kgo:
    v_add_u32 v6, s72, v28
    v_xor_b32 v7, 64, v6
    v_xor_b32 v8, 128, v6
    v_xor_b32 v9, 192, v6
    s_waitcnt vmcnt(4)
    buffer_load_dwordx4 v1, s[20:23], s48 offen offset:0 nt lds
    ds_read_b128 v[56:59], v6
    ds_read_b128 v[60:63], v7
    ds_read_b128 v[64:67], v8
    ds_read_b128 v[68:71], v9
    s_cmp_ge_u32 s80, 12
    s_cbranch_scc1 L_w1
    s_waitcnt vmcnt(4)
L_w1:
    buffer_load_dwordx4 v2, s[20:23], s48 offen offset:1024 nt lds
    v_mov_b32 v34, 0
    v_mov_b32 v35, 0
    s_waitcnt lgkmcnt(3)
    v_mfma_f32_16x16x32_bf16 v[20:23], v[40:43], v[56:59], 0
    v_dot2c_f32_bf16 v34, v56, v56
    v_dot2c_f32_bf16 v35, v57, v57
    v_dot2c_f32_bf16 v34, v58, v58
    v_dot2c_f32_bf16 v35, v59, v59
    s_waitcnt lgkmcnt(2)
    v_mfma_f32_16x16x32_bf16 v[20:23], v[44:47], v[60:63], v[20:23]
    v_dot2c_f32_bf16 v34, v60, v60
    v_dot2c_f32_bf16 v35, v61, v61
    v_dot2c_f32_bf16 v34, v62, v62
    v_dot2c_f32_bf16 v35, v63, v63
    s_waitcnt lgkmcnt(1)
    v_mfma_f32_16x16x32_bf16 v[20:23], v[48:51], v[64:67], v[20:23]
    v_dot2c_f32_bf16 v34, v64, v64
    v_dot2c_f32_bf16 v35, v65, v65
    v_dot2c_f32_bf16 v34, v66, v66
    v_dot2c_f32_bf16 v35, v67, v67
    s_waitcnt lgkmcnt(0)
    v_mfma_f32_16x16x32_bf16 v[20:23], v[52:55], v[68:71], v[20:23]
    v_dot2c_f32_bf16 v34, v68, v68
    v_dot2c_f32_bf16 v35, v69, v69
    v_dot2c_f32_bf16 v34, v70, v70
    v_dot2c_f32_bf16 v35, v71, v71
    s_nop 2
    v_add_f32 v34, v34, v35
    s_nop 1
    v_mfma_f32_16x16x4_f32 v[20:23], v14, v34, v[20:23]
    s_cmp_ge_u32 s80, 16
    s_cbranch_scc1 L_w2
    s_waitcnt vmcnt(4)
L_w2:
    buffer_load_dwordx4 v3, s[20:23], s48 offen offset:2048 nt lds
    s_nop 6
    v_mul_f32 v36, s52, v20
    v_mul_f32 v37, s52, v21
    v_exp_f32 v36, v36
    v_exp_f32 v37, v37
    s_nop 0
    v_fma_f32 v36, v30, v36, v32
    v_fma_f32 v36, v31, v37, v36
    v_add_f32 v33, v33, v36
    s_nop 0
    v_mfma_f32_16x16x4_f32 v[24:27], v15, v36, 0
    s_cmp_ge_u32 s80, 8
    s_cbranch_scc1 L_w3
    s_waitcnt vmcnt(4)
    s_cmp_ge_u32 s80, 4
    s_cbranch_scc1 L_w3
    s_waitcnt vmcnt(3)
L_w3:
    buffer_load_dwordx4 v4, s[20:23], s48 offen offset:3072 nt lds
    s_nop 6
    v_and_b32 v36, 0xffff0000, v24
    v_sub_f32 v36, v24, v36
    v_perm_b32 v36, v24, v36, s74
    s_mov_b64 exec, 0xffff
    ds_write_b32 v29, v36
    s_mov_b64 exec, -1
    v_add_u32 v29, 64, v29
    s_cmpk_lg_u32 s48, 0x4000
    s_cbranch_scc1 L_kloop
    v_and_b32 v36, 48, v0
    v_add_u32 v29, s59, v36
    ds_read_b128 v[24:27], v29
    v_add_u32 v29, 64, v29
    v_add_f32 v33, v33, v33 row_ror:8
    v_and_b32 v36, 15, v0
    v_lshl_add_u32 v7, v36, 5, s59
    v_add_f32 v33, v33, v33 row_ror:4
    v_and_b32 v36, 16, v0
    v_add_u32 v7, v36, v7
    v_add_f32 v33, v33, v33 row_ror:2
    v_and_b32 v36, 32, v0
    v_lshl_add_u32 v7, v36, 4, v7
    v_add_f32 v33, v33, v33 row_ror:1
    v_lshlrev_b32 v30, 3, v0
    v_lshlrev_b32 v31, 1, v0
    v_mfma_f32_16x16x4_f32 v[20:23], v15, v33, 0
    v_lshlrev_b32 v8, 2, v0
    v_add_u32 v8, 65536, v8
    v_subrev_u32 v36, 32, v74
    v_subrev_u32 v9, 32, v72
    s_waitcnt lgkmcnt(0)
    v_perm_b32 v40, v24, v24, v10
    v_perm_b32 v41, v24, v24, v11
    v_perm_b32 v42, v24, v24, v12
    v_perm_b32 v43, v24, v24, v13
    v_perm_b32 v44, v25, v25, v10
    v_perm_b32 v45, v25, v25, v11
    v_perm_b32 v46, v25, v25, v12
    v_perm_b32 v47, v25, v25, v13
    v_perm_b32 v48, v26, v26, v10
    v_perm_b32 v49, v26, v26, v11
    v_perm_b32 v50, v26, v26, v12
    v_perm_b32 v51, v26, v26, v13
    v_perm_b32 v52, v27, v27, v10
    v_perm_b32 v53, v27, v27, v11
    v_perm_b32 v54, v27, v27, v12
    v_perm_b32 v55, v27, v27, v13
    ds_write_b32 v36, v20
L_vloop:
    v_add3_u32 v76, v76, v77, v78
    v_mad_i32_i24 v79, v73, -4, v79
    v_add3_u32 v76, v76, v79, 2
    v_mad_i32_i24 v38, v76, 2, v38
    v_max_i32 v38, 0, v38
    v_add_u32 v73, 1, v73
    v_readfirstlane_b32 s80, v38
    ds_write_b32 v74, v73 offset:16
    ds_read_b32 v38, v72
    ds_read_b128 v[76:79], v72 offset:16
    s_or_b32 s48, s48, 0xffe0bfff
    s_add_u32 s48, s48, 1
    s_and_b32 s48, s48, 0x1f4000
    s_addk_i32 s73, 0x1000
    s_and_b32 s73, s73, 0x3000
    s_or_b32 m0, s71, s73
    s_xor_b32 s72, m0, 0x2000
    s_lshr_b32 s81, s73, 12
    s_add_u32 s80, s80, s81
    v_add_u32 v6, s72, v39
    s_waitcnt vmcnt(4)
    buffer_load_dwordx4 v1, s[20:23], s48 offen offset:0 nt lds
    ds_read_b128 v[56:59], v6 offset:0
    ds_read_b128 v[60:63], v6 offset:1024
    ds_read_b128 v[64:67], v6 offset:2048
    ds_read_b128 v[68:71], v6 offset:3072
    s_waitcnt lgkmcnt(3)
    v_mfma_f32_16x16x32_bf16 v[16:19], v[40:43], v[56:59], v[16:19]
    s_waitcnt lgkmcnt(2)
    v_mfma_f32_16x16x32_bf16 v[16:19], v[44:47], v[60:63], v[16:19]
    s_waitcnt lgkmcnt(1)
    v_mfma_f32_16x16x32_bf16 v[16:19], v[48:51], v[64:67], v[16:19]
    s_waitcnt lgkmcnt(0)
    v_mfma_f32_16x16x32_bf16 v[16:19], v[52:55], v[68:71], v[16:19]
    s_cmp_ge_u32 s80, 12
    s_cbranch_scc1 L_w4
    s_waitcnt vmcnt(4)
L_w4:
    buffer_load_dwordx4 v2, s[20:23], s48 offen offset:1024 nt lds
    ds_read_b128 v[24:27], v29
    v_add_u32 v29, 64, v29
    s_cmp_ge_u32 s80, 16
    s_cbranch_scc1 L_w5
    s_waitcnt vmcnt(4)
L_w5:
    buffer_load_dwordx4 v3, s[20:23], s48 offen offset:2048 nt lds
    s_waitcnt lgkmcnt(0)
    v_perm_b32 v40, v24, v24, v10
    v_perm_b32 v41, v24, v24, v11
    v_perm_b32 v42, v24, v24, v12
    v_perm_b32 v43, v24, v24, v13
    v_perm_b32 v44, v25, v25, v10
    v_perm_b32 v45, v25, v25, v11
    v_perm_b32 v46, v25, v25, v12
    v_perm_b32 v47, v25, v25, v13
    s_cmp_ge_u32 s80, 8
    s_cbranch_scc1 L_w6
    s_waitcnt vmcnt(4)
    s_cmp_ge_u32 s80, 4
    s_cbranch_scc1 L_w6
    s_waitcnt vmcnt(3)
L_w6:
    buffer_load_dwordx4 v4, s[20:23], s48 offen offset:3072 nt lds
    v_perm_b32 v48, v26, v26, v10
    v_perm_b32 v49, v26, v26, v11
    v_perm_b32 v50, v26, v26, v12
    v_perm_b32 v51, v26, v26, v13
    v_perm_b32 v52, v27, v27, v10
    v_perm_b32 v53, v27, v27, v11
    v_perm_b32 v54, v27, v27, v12
    v_perm_b32 v55, v27, v27, v13
    s_cmp_lg_u32 s48, 0xf4000
    s_cbranch_scc1 L_vloop
    v_xor_b32 v6, 0x3000, v6
    s_waitcnt vmcnt(4)
    ds_read_b128 v[56:59], v6 offset:0
    ds_read_b128 v[60:63], v6 offset:1024
    ds_read_b128 v[64:67], v6 offset:2048
    ds_read_b128 v[68:71], v6 offset:3072
    ds_read_b128 v[24:27], v29
    s_waitcnt lgkmcnt(4)
    v_mfma_f32_16x16x32_bf16 v[16:19], v[40:43], v[56:59], v[16:19]
    s_waitcnt lgkmcnt(3)
    v_mfma_f32_16x16x32_bf16 v[16:19], v[44:47], v[60:63], v[16:19]
    s_waitcnt lgkmcnt(2)
    v_mfma_f32_16x16x32_bf16 v[16:19], v[48:51], v[64:67], v[16:19]
    s_waitcnt lgkmcnt(1)
    v_mfma_f32_16x16x32_bf16 v[16:19], v[52:55], v[68:71], v[16:19]
    v_xor_b32 v6, 0x1000, v6
    s_waitcnt lgkmcnt(0)
    v_perm_b32 v40, v24, v24, v10
    v_perm_b32 v41, v24, v24, v11
    v_perm_b32 v42, v24, v24, v12
    v_perm_b32 v43, v24, v24, v13
    v_perm_b32 v44, v25, v25, v10
    v_perm_b32 v45, v25, v25, v11
    v_perm_b32 v46, v25, v25, v12
    v_perm_b32 v47, v25, v25, v13
    v_perm_b32 v48, v26, v26, v10
    v_perm_b32 v49, v26, v26, v11
    v_perm_b32 v50, v26, v26, v12
    v_perm_b32 v51, v26, v26, v13
    v_perm_b32 v52, v27, v27, v10
    v_perm_b32 v53, v27, v27, v11
    v_perm_b32 v54, v27, v27, v12
    v_perm_b32 v55, v27, v27, v13
    s_waitcnt vmcnt(1)
    ds_read_b128 v[56:59], v6 offset:0
    ds_read_b128 v[60:63], v6 offset:1024
    ds_read_b128 v[64:67], v6 offset:2048
    s_waitcnt lgkmcnt(2)
    v_mfma_f32_16x16x32_bf16 v[16:19], v[40:43], v[56:59], v[16:19]
    s_waitcnt lgkmcnt(1)
    v_mfma_f32_16x16x32_bf16 v[16:19], v[44:47], v[60:63], v[16:19]
    s_waitcnt lgkmcnt(0)
    v_mfma_f32_16x16x32_bf16 v[16:19], v[48:51], v[64:67], v[16:19]
    s_waitcnt vmcnt(0)
    ds_read_b128 v[68:71], v6 offset:3072
    s_waitcnt lgkmcnt(0)
    v_mfma_f32_16x16x32_bf16 v[16:19], v[52:55], v[68:71], v[16:19]
    s_nop 6
    s_cmpk_ge_u32 s70, 128
    ds_write_b128 v7, v[16:19]
    s_waitcnt lgkmcnt(0)
    s_barrier
    s_cbranch_scc1 L_end
    ds_read_b128 v[48:51], v9
    ds_read2st64_b32 v[40:41], v8 offset0:0 offset1:2
    ds_read2st64_b32 v[42:43], v8 offset0:8 offset1:10
    ds_read2st64_b32 v[44:45], v8 offset0:16 offset1:18
    ds_read2st64_b32 v[46:47], v8 offset0:24 offset1:26
    s_waitcnt lgkmcnt(2)
    v_pk_add_f32 v[48:49], v[48:49], v[50:51]
    v_pk_add_f32 v[40:41], v[40:41], v[42:43]
    v_add_f32 v53, v48, v49
    s_waitcnt lgkmcnt(0)
    v_pk_add_f32 v[44:45], v[44:45], v[46:47]
    v_and_b32 v43, 0x7fffffff, v53
    v_pk_add_f32 v[40:41], v[40:41], v[44:45]
    v_add_f32 v42, v40, v41
    buffer_atomic_swap_x2 v[42:43], v30, s[44:47], 0 offen sc0
    v_add_f32 v52, v40, v41
    s_waitcnt vmcnt(0)
    v_cmp_le_i32 vcc, 0, v43
    v_pk_add_f32 v[42:43], v[42:43], v[52:53]
    s_and_saveexec_b64 s[56:57], vcc
    s_cbranch_execz L_end
    v_add_f32 v43, s54, v43
    v_rcp_f32 v44, v43
    s_nop 0
    v_mul_f32 v42, v42, v44
    v_cvt_pk_bf16_f32 v42, v42, v42
    buffer_store_short v42, v31, s[36:39], 0 offen
L_end:
    s_endpgm
L_helper:
    v_mov_b32 v1, 77856
    v_mov_b32 v2, 6
    v_mov_b32 v4, 1
    v_mov_b32 v5, 1
    v_mov_b32 v6, 1
    v_mov_b32 v7, 1
    ds_write_b32 v1, v2
    ds_write_b128 v1, v[4:7] offset:16
    s_waitcnt lgkmcnt(0)
    s_barrier
    s_cmp_lg_u32 s19, 0
    s_cbranch_scc1 L_h2
    s_lshl_b32 s57, 1, s50
    s_waitcnt vmcnt(0)
    s_atomic_or s57, s[14:15], 0
L_h2:
    s_mov_b32 s26, 0
    s_bfe_u32 s52, s2, 0x30003
    s_lshl_b32 s52, s52, 8
    s_add_u32 s52, s52, 0x20000
    s_lshr_b32 s51, s2, 2
    s_xor_b32 s51, s51, s2
    s_bfe_u32 s51, s51, 0x30003
    s_and_b32 s53, s2, 1
    s_xor_b32 s51, s51, s53
    s_lshl_b32 s51, s51, 8
    s_mov_b32 s80, 0x33221100
    s_mov_b32 s81, 0x77665544
    s_mov_b32 s82, 0xaa999888
    s_mov_b32 s83, 0xfdccbbba
    s_mov_b32 s84, 0x8040200
    s_mov_b32 s85, 0x11081010
L_next:
    s_ff1_i32_b64 s53, s[84:85]
    s_cmp_lt_i32 s53, 0
    s_cbranch_scc1 L_hend
    s_bitset0_b64 s[84:85], s53
    s_lshl_b32 s53, s53, 2
L_poll:
    ds_read_b128 v[4:7], v1 offset:16
    s_waitcnt lgkmcnt(0)
    v_add_u32 v4, v4, v5
    v_add3_u32 v4, v4, v6, v7
    s_nop 0
    v_readfirstlane_b32 s55, v4
    s_nop 1
    s_cmp_lt_u32 s55, s53
    s_cbranch_scc1 L_poll
    s_cmpk_eq_u32 s26, 0xffff
    s_cbranch_scc1 L_rank
    s_load_dword s26, s[14:15], 0
L_flag:
    s_waitcnt lgkmcnt(0)
    s_and_b32 s26, s26, 0xffff
    s_cmpk_eq_u32 s26, 0xffff
    s_cbranch_scc1 L_rank
    s_sleep 16
    s_mov_b32 s26, 0
    s_atomic_or s26, s[14:15], 0 glc
    s_branch L_flag
L_rank:
    s_mov_b32 s55, 1
    s_atomic_add s55, s[16:17], s52 glc
    s_waitcnt lgkmcnt(0)
    s_addk_i32 s52, 2048
    s_xor_b32 s52, s52, s51
    s_add_u32 s55, s55, 1
    s_bitcmp1_b32 s55, 4
    s_cselect_b64 s[58:59], s[82:83], s[80:81]
    s_lshl_b32 s55, s55, 2
    s_lshr_b64 s[58:59], s[58:59], s55
    s_and_b32 s58, s58, 15
    v_mov_b32 v2, s58
    ds_write_b32 v1, v2
    s_branch L_next
L_hend:
    s_barrier
    s_endpgm
.section .rodata,"a"
.p2align 6
.amdhsa_kernel standalone__linear_kernel_rfa__decode_kernel
  .amdhsa_next_free_vgpr 80
  .amdhsa_next_free_sgpr 88
  .amdhsa_accum_offset 80
  .amdhsa_group_segment_fixed_size 0
  .amdhsa_kernarg_size 56
  .amdhsa_user_sgpr_count 2
  .amdhsa_user_sgpr_kernarg_segment_ptr 1
  .amdhsa_system_sgpr_workgroup_id_x 1
  .amdhsa_float_denorm_mode_32 3
.end_amdhsa_kernel
```
